```python
import torch

def _softmax(x, axis=-1):
    return torch.softmax(x, dim=axis)
def _gelu(x):
    return torch.nn.functional.gelu(x, approximate="tanh")
def _silu(x):
    return torch.nn.functional.silu(x)
def _sigmoid(x):
    return torch.sigmoid(x)
def _layernorm(x, axis=-1, eps=1e-5):
    m = x.mean(dim=axis, keepdim=True)
    v = x.var(dim=axis, keepdim=True, unbiased=False)
    return (x - m) / torch.sqrt(v + eps)
def _scatter_add(tgt, idx, src, axis=0):
    return tgt.clone().index_add_(axis, idx, src)
def _segment_sum(src, seg, n):
    out = torch.zeros((n,) + src.shape[1:], dtype=src.dtype)
    return out.index_add_(0, seg, src)
def _pad(x, pw):
    flat = tuple(v for pair in reversed(pw) for v in pair)
    return torch.nn.functional.pad(x, flat)

kernel_name = 'gated_mix__sliding_block_cached__glu_gated_swiglu__decode'

def setup_inputs():

    _w = (lambda a: (lambda t: t.to(torch.bfloat16) if t.is_floating_point() else t)(torch.as_tensor(a)))
    def _A_setup():
        B, Sq, D = 8, 1, 512
        Hq, Hkv, Sk, Dh = 32, 32, 4096, 128
        assert Hq % Hkv == 0, (Hq, Hkv)
        return {
            "x": _w((lambda *s: torch.randn(*s, dtype=torch.bfloat16) * 0.05)(B, Sq, D)),
            "k_cache": _w((lambda *s: torch.randn(*s, dtype=torch.bfloat16) * 3.2)(B, Hkv, Sk, Dh)),
            "v_cache": _w((lambda *s: torch.randn(*s, dtype=torch.bfloat16) * 0.05)(B, Hkv, Sk, Dh)),
            "wq": _w((lambda *s: torch.randn(*s, dtype=torch.bfloat16) * 3.2)(D, Hq * Dh) * (D ** -0.5)),
            "wo": _w((lambda *s: torch.randn(*s, dtype=torch.bfloat16) * 0.05)(Hq * Dh, D) * ((Hq * Dh) ** -0.5)),
        }
    _A_in = _A_setup()

    def _B_setup():
        B, S, D, F = 8, 1, 512, 1376
        return {
            "x": _w((lambda *s: torch.randn(*s, dtype=torch.bfloat16) * 0.05)(B, S, D)),
            "w1": _w((lambda *s: torch.randn(*s, dtype=torch.bfloat16) * 0.2)(D, F) * (2.0 / D) ** 0.5),
            "w3": _w((lambda *s: torch.randn(*s, dtype=torch.bfloat16) * 0.2)(D, F) * (2.0 / D) ** 0.5),
            "w2": _w((lambda *s: torch.randn(*s, dtype=torch.bfloat16) * 0.2)(F, D) * (2.0 / F) ** 0.5),
        }
    _B_in = _B_setup()

    return {
        "A_x": _A_in["x"],
        "A_k_cache": _A_in["k_cache"],
        "A_v_cache": _A_in["v_cache"],
        "A_wq": _A_in["wq"],
        "A_wo": _A_in["wo"],
        "B_x": _B_in["x"],
        "B_w1": _B_in["w1"],
        "B_w3": _B_in["w3"],
        "B_w2": _B_in["w2"],
        "gate_w": _w((lambda *s: torch.randn(*s, dtype=torch.bfloat16) * 0.05)(512) * 16.0),
    }

def reference(A_x, A_k_cache, A_v_cache, A_wq, A_wo, B_x, B_w1, B_w3, B_w2, gate_w):
    def _A_ref(x, k_cache, v_cache, wq, wo):
        B, Sq, D = x.shape
        Hq, Dh = 32, 128
        Hkv, Sk = k_cache.shape[1], k_cache.shape[2]
        W = min(4096, max(256, Sk // 4))
        rep = Hq // Hkv
        q = (lambda x, *d: x.permute(*d))((x @ wq).reshape(B, Sq, Hq, Dh), 0, 2, 1, 3)
        k = (lambda x, n, axis: torch.repeat_interleave(x, n, dim=axis))(k_cache[:, :, Sk - W:, :], rep, axis=1)
        v = (lambda x, n, axis: torch.repeat_interleave(x, n, dim=axis))(v_cache[:, :, Sk - W:, :], rep, axis=1)
        scores = torch.einsum("bhqd,bhkd->bhqk", q, k) * (Dh ** -0.5)
        p = _softmax(scores, axis=-1)
        o = torch.einsum("bhqk,bhkd->bhqd", p, v)
        return (lambda x, *d: x.permute(*d))(o, 0, 2, 1, 3).reshape(B, Sq, Hq * Dh) @ wo

    def _B_ref(x, w1, w3, w2):
        gate = torch.einsum("bsd,df->bsf", x, w1)
        up = torch.einsum("bsd,df->bsf", x, w3)
        h = _silu(gate) * up
        out = torch.einsum("bsf,fd->bsd", h, w2)
        return out

    x = A_x
    g = _sigmoid((x * gate_w).sum(-1, keepdims=True))
    a = _A_ref(x, A_k_cache, A_v_cache, A_wq, A_wo)
    b = _B_ref(x, B_w1, B_w3, B_w2)
    return g * a + (1 - g) * b
```

```asm
; @launch grid=(256,1,1) block=(512,1,1) lds=23552
.amdgcn_target "amdgcn-amd-amdhsa--gfx950"
.text
.globl gated_mix__sliding_block_cached__glu_gated_swiglu__decode_kernel
.p2align 8
.type gated_mix__sliding_block_cached__glu_gated_swiglu__decode_kernel,@function
gated_mix__sliding_block_cached__glu_gated_swiglu__decode_kernel:
    s_load_dwordx2 s[12:13], s[0:1], 32
    s_load_dwordx2 s[28:29], s[0:1], 96
    s_lshr_b32 s3, s2, 8
    s_cbranch_scc1 L_end
    v_and_b32 v1, 63, v0
    v_lshrrev_b32 v5, 6, v0
    v_lshlrev_b32 v123, 7, v1
    v_lshl_add_u32 v6, v5, 11, v123
    s_getpc_b64 s[52:53]
L_pc:
    v_min_u32 v48, L_end-L_pc, v6
    v_mov_b32 v49, 0
    v_lshl_add_u64 v[48:49], v[48:49], 0, s[52:53]
    s_mov_b64 exec, 0xffff
    global_load_dword v16, v[48:49], off
    s_lshr_b32 s44, s2, 5
    s_and_b32 s45, s2, 31
    s_lshl3_add_u32 s56, s45, s44
    s_lshl_b32 s56, s56, 14
    s_lshl_b32 s14, 1, 22
    s_mov_b32 s15, 0x20000
    s_waitcnt lgkmcnt(0)
    buffer_load_dword v17, v6, s[12:15], s56 offen
    s_mov_b64 exec, -1
    s_load_dwordx2 s[4:5], s[0:1], 8
    v_readfirstlane_b32 s3, v5
    s_bfe_u32 s70, s2, 0x20005
    s_load_dwordx2 s[24:25], s[0:1], 0
    s_lshl3_add_u32 s86, s70, 32
    s_cmp_lt_u32 s70, 2
    s_cselect_b32 s86, 24, s86
    s_load_dwordx2 s[20:21], s[0:1], s86
    s_load_dwordx2 s[16:17], s[0:1], 64
    s_and_b32 s87, s45, 7
    s_lshr_b32 s88, s45, 3
    s_lshl2_add_u32 s87, s87, s88
    s_mul_i32 s87, s87, 699056
    s_add_u32 s87, s87, 87382
    s_lshr_b32 s78, s87, 17
    s_add_u32 s87, s87, 699056
    s_lshr_b32 s79, s87, 17
    s_cmp_eq_u32 s79, 171
    s_addc_u32 s79, s79, 0
    s_sub_u32 s89, s79, s78
    s_movk_i32 s26, 8192
    s_lshl1_add_u32 s87, s45, s70
    s_lshl_b32 s87, s87, 7
    s_lshl_b32 s88, s78, 4
    s_cmp_lt_u32 s70, 2
    s_cselect_b32 s76, s26, 2752
    s_cselect_b32 s87, s87, s88
    s_cselect_b32 s89, 8, s89
    s_lshl_b32 s22, s76, 9
    s_mov_b32 s23, s15
    s_mov_b32 s27, s15
    s_lshr_b32 s88, s44, 2
    s_lshl3_add_u32 s88, s88, s3
    s_lshl_b32 s69, s88, 6
    s_lshl_b32 s88, s88, 5
    s_mul_i32 s88, s88, s76
    s_add_u32 s68, s87, s88
    s_mul_i32 s67, s76, 15
    v_bfe_u32 v48, v0, 3, 3
    v_and_b32 v7, 7, v0
    v_lshlrev_b32 v49, 1, v48
    v_lshlrev_b32 v55, 4, v7
    v_cmp_gt_u32 vcc, s89, v7
    v_mad_u32_u24 v52, v49, s76, v55
    v_bfrev_b32 v50, 1
    v_cndmask_b32 v52, v50, v52, vcc
    v_lshlrev_b32 v7, 3, v7
    v_lshl_add_u32 v51, v48, 10, v7
    s_waitcnt lgkmcnt(0)
    buffer_load_dwordx2 v[112:113], v51, s[24:27], s69 offen
    buffer_load_dwordx4 v[56:59], v52, s[20:23], s68 offen nt
    s_add_u32 s68, s68, s76
    buffer_load_dwordx4 v[60:63], v52, s[20:23], s68 offen nt
    s_add_u32 s68, s68, s67
    buffer_load_dwordx4 v[64:67], v52, s[20:23], s68 offen nt
    s_add_u32 s68, s68, s76
    buffer_load_dwordx4 v[68:71], v52, s[20:23], s68 offen nt
    s_lshl_b32 s18, s79, 13
    s_mov_b32 s19, s15
    s_lshl3_add_u32 s56, s44, s3
    s_mul_i32 s55, s56, 768
    s_lshl_b32 s87, s78, 13
    s_add_u32 s55, s55, s87
    s_mov_b64 exec, 63
    buffer_load_dword v18, v123, s[16:19], s55 offen
    s_mov_b32 s30, 8388608
    s_mov_b32 s31, 0x20000
    s_lshl3_add_u32 s55, s44, s3
    s_lshl_b32 s55, s55, 8
    s_lshl_b32 s87, s45, 15
    s_add_u32 s55, s55, s87
    s_mov_b64 exec, 3
    buffer_load_dword v19, v123, s[28:31], s55 offen
    s_mov_b64 exec, -1
    v_lshlrev_b32 v1, 4, v1
    s_lshl_b32 s74, s2, 20
    v_lshl_add_u32 v4, v5, 12, v1
    s_add_u32 s74, s74, 0xc0000
    s_brev_b32 s6, 8
    s_mov_b32 s7, s15
    s_mov_b32 s57, s74
    s_mov_b32 s75, 0x8000
    buffer_load_dwordx4 v[128:131], v4, s[4:7], s74 offen offset:0 nt
    buffer_load_dwordx4 v[132:135], v4, s[4:7], s74 offen offset:1024 nt
    buffer_load_dwordx4 v[136:139], v4, s[4:7], s74 offen offset:2048 nt
    s_load_dwordx2 s[8:9], s[0:1], 16
    s_load_dwordx2 s[32:33], s[0:1], 88
    s_load_dwordx2 s[36:37], s[0:1], 80
    s_load_dwordx2 s[40:41], s[0:1], 72
    s_lshl_b32 s81, s45, 15
    s_lshl_b32 s87, s3, 7
    s_add_u32 s99, s81, 0x4000
    s_lshl_b32 s88, s44, 7
    s_add_u32 s100, s99, s88
    s_add_u32 s99, s99, s87
    s_waitcnt lgkmcnt(0)
    s_load_dword s98, s[28:29], s100
    s_load_dword s85, s[28:29], s99
    s_brev_b32 s10, 8
    s_mov_b32 s11, 0x20000
    s_movk_i32 s34, 256
    s_mov_b32 s35, 0x20000
    s_movk_i32 s38, 8192
    s_mov_b32 s39, 0x20000
    s_movk_i32 s42, 1024
    s_mov_b32 s43, 0x20000
    s_cmp_lg_u32 s3, 0
    s_cbranch_scc1 L_nogl
    s_lshl_b32 s88, s44, 10
    buffer_load_dwordx4 v[40:43], v1, s[24:27], s88 offen
    buffer_load_dwordx4 v[44:47], v1, s[40:43], 0 offen
L_nogl:
    s_mov_b32 s46, 0x05040100
    s_mov_b32 s47, 0x07060302
    s_movk_i32 s84, 16384
    s_mov_b32 s93, 0x3fb8aa3b
    s_mov_b32 s94, 0x3db504f3
    s_mov_b32 s95, 0xffff0000
    s_lshl_b32 s89, s78, 13
    s_add_u32 s89, s89, s87
    v_lshl_add_u32 v3, v49, 10, v55
    v_add_u32 v3, s89, v3
    s_lshl_b32 s89, s45, 17
    s_add_u32 s89, s89, s87
    v_add_u32 v2, s89, v55
    v_bfe_u32 v5, v0, 4, 2
    v_lshl_add_u32 v2, v5, 12, v2
    v_bfe_u32 v6, v0, 3, 1
    v_lshl_add_u32 v2, v6, 10, v2
    v_lshl_add_u32 v54, v48, 11, v55
    v_and_b32 v6, 1, v0
    v_lshl_add_u32 v6, v5, 1, v6
    v_lshlrev_b32 v124, 2, v6
    s_lshl_b32 s89, s44, 11
    s_add_u32 s80, s81, s89
    s_lshl_b32 s89, s3, 8
    s_add_u32 s80, s80, s89
    s_lshl_b32 s89, s44, 8
    s_add_u32 s81, s81, s89
    s_and_b32 s89, s87, 128
    s_add_u32 s81, s81, s89
    s_lshr_b32 s101, s2, 3
    s_lshl_b32 s101, s101, 3
    s_add_u32 s101, s101, s3
    v_and_b32 v6, 1, v0
    v_lshlrev_b32 v6, 4, v6
    v_mov_b32 v7, 0xffff
    v_lshlrev_b32 v6, v6, v7
    v_bfe_u32 v7, v0, 1, 2
    v_cmp_eq_u32 vcc, 0, v7
    v_mov_b32 v116, 0
    v_mov_b32 v117, 0
    v_cndmask_b32 v12, 0, v6, vcc
    v_cmp_eq_u32 vcc, 1, v7
    v_mov_b32 v118, 0
    v_mov_b32 v119, 0
    v_cndmask_b32 v13, 0, v6, vcc
    v_cmp_eq_u32 vcc, 2, v7
    v_mov_b32 v30, 1.0
    v_mov_b32 v31, 1.0
    v_cndmask_b32 v14, 0, v6, vcc
    v_cmp_eq_u32 vcc, 3, v7
    v_mov_b32 v126, 0
    v_mov_b32 v127, 0
    v_cndmask_b32 v15, 0, v6, vcc
    v_bfe_u32 v122, v0, 4, 2
    v_and_b32 v6, 15, v0
    v_lshlrev_b32 v122, 6, v122
    v_lshl_add_u32 v122, v6, 2, v122
    s_lshr_b32 s88, s2, 3
    s_cmp_lg_u32 s88, 1
    s_cbranch_scc1 L_nozero
    s_and_b32 s88, s2, 7
    s_lshl_b32 s88, s88, 3
    s_add_u32 s88, s88, s3
    s_lshl_b32 s88, s88, 9
    s_add_u32 s88, s88, 1048576
    buffer_store_dword v116, v122, s[28:31], s88 offen sc1
    buffer_store_dword v116, v122, s[28:31], s88 offen offset:256 sc1
L_nozero:
    s_and_b32 s50, s2, 7
    s_lshl_b32 s50, s50, 3
    s_add_u32 s50, s50, s3
    s_lshl_b32 s50, s50, 9
    s_add_u32 s50, s50, 2097152
    s_lshr_b32 s49, s2, 3
    s_lshl_b32 s49, 1, s49
    buffer_load_dword v123, v122, s[28:31], s50 offen offset:0
    buffer_load_dword v125, v122, s[28:31], s50 offen offset:256
    s_waitcnt vmcnt(4)
    buffer_load_dwordx4 v[140:143], v4, s[4:7], s74 offen offset:3072 nt
    s_waitcnt vmcnt(4)
    s_add_u32 s74, s74, s75
    buffer_load_dwordx4 v[144:147], v4, s[4:7], s74 offen offset:0 nt
    s_lshl_b32 s87, s3, 9
    s_add_u32 s87, s87, 3072
    v_lshrrev_b32 v24, 1, v1
    v_add_u32 v24, s87, v24
    v_bfe_u32 v25, v0, 1, 3
    v_lshl_add_u32 v25, v25, 6, v124
    v_add_u32 v25, s87, v25
    ds_write_b64 v24, v[112:113]
    ds_read2_b32 v[112:113], v25 offset0:0 offset1:8
    s_lshl_b32 s87, s3, 11
    v_lshl_add_u32 v26, v1, 1, s87
    v_perm_b32 v208, v60, v56, s46
    v_perm_b32 v210, v60, v56, s47
    v_perm_b32 v212, v61, v57, s46
    v_perm_b32 v214, v61, v57, s47
    v_perm_b32 v216, v62, v58, s46
    v_perm_b32 v218, v62, v58, s47
    v_perm_b32 v220, v63, v59, s46
    v_perm_b32 v222, v63, v59, s47
    v_perm_b32 v209, v68, v64, s46
    v_perm_b32 v211, v68, v64, s47
    v_perm_b32 v213, v69, v65, s46
    v_perm_b32 v215, v69, v65, s47
    v_perm_b32 v217, v70, v66, s46
    v_perm_b32 v219, v70, v66, s47
    v_perm_b32 v221, v71, v67, s46
    v_perm_b32 v223, v71, v67, s47
    s_waitcnt lgkmcnt(0)
    v_mfma_f32_16x16x16_bf16 v[224:227], v[112:113], v[208:209], 0
    v_mfma_f32_16x16x16_bf16 v[228:231], v[112:113], v[210:211], 0
    v_mfma_f32_16x16x16_bf16 v[232:235], v[112:113], v[212:213], 0
    v_mfma_f32_16x16x16_bf16 v[236:239], v[112:113], v[214:215], 0
    v_mfma_f32_16x16x16_bf16 v[240:243], v[112:113], v[216:217], 0
    v_mfma_f32_16x16x16_bf16 v[244:247], v[112:113], v[218:219], 0
    v_mfma_f32_16x16x16_bf16 v[248:251], v[112:113], v[220:221], 0
    v_mfma_f32_16x16x16_bf16 v[252:255], v[112:113], v[222:223], 0
    s_nop 0
    v_add_f32_dpp v104, v225, v224 row_ror:8 row_mask:0xf bank_mask:0x3
    v_add_f32_dpp v105, v229, v228 row_ror:8 row_mask:0xf bank_mask:0x3
    v_add_f32_dpp v106, v233, v232 row_ror:8 row_mask:0xf bank_mask:0x3
    v_add_f32_dpp v107, v237, v236 row_ror:8 row_mask:0xf bank_mask:0x3
    v_add_f32_dpp v108, v241, v240 row_ror:8 row_mask:0xf bank_mask:0x3
    v_add_f32_dpp v109, v245, v244 row_ror:8 row_mask:0xf bank_mask:0x3
    v_add_f32_dpp v110, v249, v248 row_ror:8 row_mask:0xf bank_mask:0x3
    v_add_f32_dpp v111, v253, v252 row_ror:8 row_mask:0xf bank_mask:0x3
    v_add_f32_dpp v104, v226, v227 row_ror:8 row_mask:0xf bank_mask:0xc
    v_add_f32_dpp v105, v230, v231 row_ror:8 row_mask:0xf bank_mask:0xc
    v_add_f32_dpp v106, v234, v235 row_ror:8 row_mask:0xf bank_mask:0xc
    v_add_f32_dpp v107, v238, v239 row_ror:8 row_mask:0xf bank_mask:0xc
    v_add_f32_dpp v108, v242, v243 row_ror:8 row_mask:0xf bank_mask:0xc
    v_add_f32_dpp v109, v246, v247 row_ror:8 row_mask:0xf bank_mask:0xc
    v_add_f32_dpp v110, v250, v251 row_ror:8 row_mask:0xf bank_mask:0xc
    v_add_f32_dpp v111, v254, v255 row_ror:8 row_mask:0xf bank_mask:0xc
    ds_write_b128 v26, v[104:107] offset:7168
    ds_write_b128 v26, v[108:111] offset:7184
    s_getreg_b32 s92, hwreg(HW_REG_XCC_ID, 0, 3)
    s_add_u32 s98, s98, 0x08010101
    s_add_u32 s85, s85, 0x08010101
    s_lshl_b32 s92, s92, 24
    s_and_b32 s73, s98, 0xf8ffffff
    s_or_b32 s73, s73, s92
    s_and_b32 s85, s85, 0xf8ffffff
    s_or_b32 s85, s85, s92
    v_and_b32 v24, 0xf0, v1
    v_bfe_u32 v25, v0, 4, 2
    s_lshl_b32 s87, s3, 8
    v_lshl_add_u32 v25, v25, 11, v24
    v_add_u32 v25, s87, v25
    v_bfe_u32 v26, v0, 4, 1
    v_bfe_u32 v27, v0, 5, 1
    v_lshl_add_u32 v26, v26, 1, v27
    v_lshl_add_u32 v24, v26, 2, v24
    v_lshlrev_b32 v26, 3, v26
    v_lshrrev_b32 v26, v26, s85
    s_movk_i32 s88, 0xff
    s_waitcnt vmcnt(4)
    buffer_load_dwordx4 v[148:151], v4, s[4:7], s74 offen offset:1024 nt
    s_waitcnt lgkmcnt(0)
    s_barrier
    ds_read_b128 v[104:107], v25 offset:7168
    ds_read_b128 v[108:111], v25 offset:15360
    s_waitcnt lgkmcnt(0)
    v_pk_add_f32 v[104:105], v[104:105], v[108:109]
    v_pk_add_f32 v[106:107], v[106:107], v[110:111]
    s_nop 0
    v_permlane32_swap_b32 v104, v105
    v_permlane32_swap_b32 v106, v107
    v_add_f32 v104, v104, v105
    v_add_f32 v106, v106, v107
    s_nop 1
    v_permlane16_swap_b32 v104, v106
    v_add_f32 v104, v104, v106
    v_bfi_b32 v104, s88, v26, v104
    buffer_store_dword v104, v24, s[28:31], s80 offen
    s_waitcnt vmcnt(3)
    buffer_load_dwordx4 v[152:155], v4, s[4:7], s74 offen offset:2048 nt
    s_cmp_lg_u32 s3, 0
    s_cbranch_scc1 L_nogate
    v_lshlrev_b32 v32, 16, v40
    v_and_b32 v33, s95, v40
    v_lshlrev_b32 v34, 16, v44
    v_and_b32 v35, s95, v44
    v_mul_f32 v32, v32, v34
    v_mul_f32 v33, v33, v35
    v_cvt_pk_bf16_f32 v40, v32, v33
    v_lshlrev_b32 v32, 16, v41
    v_and_b32 v33, s95, v41
    v_lshlrev_b32 v34, 16, v45
    v_and_b32 v35, s95, v45
    v_mul_f32 v32, v32, v34
    v_mul_f32 v33, v33, v35
    v_cvt_pk_bf16_f32 v41, v32, v33
    v_lshlrev_b32 v32, 16, v42
    v_and_b32 v33, s95, v42
    v_lshlrev_b32 v34, 16, v46
    v_and_b32 v35, s95, v46
    v_mul_f32 v32, v32, v34
    v_mul_f32 v33, v33, v35
    v_cvt_pk_bf16_f32 v42, v32, v33
    v_lshlrev_b32 v32, 16, v43
    v_and_b32 v33, s95, v43
    v_lshlrev_b32 v34, 16, v47
    v_and_b32 v35, s95, v47
    v_mul_f32 v32, v32, v34
    v_mul_f32 v33, v33, v35
    v_cvt_pk_bf16_f32 v43, v32, v33
    v_mov_b32 v32, 0
    v_mov_b32 v33, 0x3f803f80
    v_dot2c_f32_bf16 v32, v40, v33
    v_dot2c_f32_bf16 v32, v41, v33
    v_dot2c_f32_bf16 v32, v42, v33
    v_dot2c_f32_bf16 v32, v43, v33
    s_nop 2
    v_add_f32_dpp v32, v32, v32 quad_perm:[1,0,3,2] row_mask:0xf bank_mask:0xf
    s_nop 1
    v_add_f32_dpp v32, v32, v32 quad_perm:[2,3,0,1] row_mask:0xf bank_mask:0xf
    s_nop 1
    v_add_f32_dpp v32, v32, v32 row_ror:4 row_mask:0xf bank_mask:0xf
    s_nop 1
    v_add_f32_dpp v32, v32, v32 row_ror:8 row_mask:0xf bank_mask:0xf
    v_mov_b32 v33, v32
    s_nop 1
    v_permlane16_swap_b32 v32, v33
    v_add_f32 v32, v32, v33
    v_mov_b32 v33, v32
    s_nop 1
    v_permlane32_swap_b32 v32, v33
    v_add_f32 v32, v32, v33
    v_cvt_pk_bf16_f32 v32, v32, v32
    v_and_b32 v32, s95, v32
    v_mul_f32 v32, s93, v32
    v_exp_f32 v32, -v32
    s_nop 0
    v_add_f32 v32, 1.0, v32
    v_rcp_f32 v32, v32
    s_nop 0
    v_cvt_pk_bf16_f32 v32, v32, v32
    v_and_b32 v32, s95, v32
    v_sub_f32 v33, 1.0, v32
    v_cvt_pk_bf16_f32 v33, v33, v33
    v_and_b32 v33, s95, v33
    ds_write_b64 v116, v[32:33] offset:2816
L_nogate:
    s_waitcnt vmcnt(3)
    buffer_load_dwordx4 v[156:159], v4, s[4:7], s74 offen offset:3072 nt
    s_waitcnt vmcnt(3)
    s_add_u32 s74, s74, s75
    buffer_load_dwordx4 v[160:163], v4, s[4:7], s74 offen offset:0 nt
    v_add_u32 v36, 1, v123
    s_mov_b32 exec_lo, s49
    s_mov_b32 exec_hi, 0
    buffer_store_dword v36, v122, s[28:31], s50 offen offset:0
    s_mov_b32 exec_lo, -1
    s_mov_b32 exec_hi, 0
    buffer_load_dword v37, v122, s[28:31], s50 offen offset:0 sc1
    s_mov_b64 exec, -1
    s_waitcnt vmcnt(4)
    buffer_load_dwordx4 v[164:167], v4, s[4:7], s74 offen offset:1024 nt
    buffer_load_dwordx4 v[72:75], v3, s[16:19], 0 offen offset:0 nt
    s_waitcnt vmcnt(5)
    buffer_load_dwordx4 v[168:171], v4, s[4:7], s74 offen offset:2048 nt
    s_waitcnt vmcnt(5)
    buffer_load_dwordx4 v[172:175], v4, s[4:7], s74 offen offset:3072 nt
    buffer_load_dwordx4 v[76:79], v3, s[16:19], 0 offen offset:1024 nt
    s_waitcnt vmcnt(4)
    s_add_u32 s74, s74, s75
    buffer_load_dwordx4 v[176:179], v4, s[4:7], s74 offen offset:0 nt
    v_cmp_ne_u32 vcc, v37, v123
    s_bcnt1_i32_b32 s48, vcc_lo
    s_sub_i32 s48, 32, s48
    s_max_i32 s48, s48, 0
    s_mul_i32 s48, s48, 2
    s_lshr_b32 s48, s48, 3
    s_waitcnt vmcnt(3)
    s_cmp_le_u32 s48, 0
    s_cbranch_scc1 L_th1
    s_waitcnt vmcnt(2)
L_th1:
    buffer_load_dwordx4 v[180:183], v4, s[4:7], s74 offen offset:1024 nt
    buffer_load_dwordx4 v[80:83], v3, s[16:19], s84 offen offset:0 nt
    s_waitcnt vmcnt(4)
    s_cmp_le_u32 s48, 1
    s_cbranch_scc1 L_th2
    s_waitcnt vmcnt(2)
L_th2:
    buffer_load_dwordx4 v[184:187], v4, s[4:7], s74 offen offset:2048 nt
    s_waitcnt vmcnt(3)
    s_cmp_le_u32 s48, 2
    s_cbranch_scc1 L_th3
    s_waitcnt vmcnt(2)
L_th3:
    buffer_load_dwordx4 v[188:191], v4, s[4:7], s74 offen offset:3072 nt
    buffer_load_dwordx4 v[84:87], v3, s[16:19], s84 offen offset:1024 nt
    s_waitcnt vmcnt(4)
    s_cmp_le_u32 s48, 3
    s_cbranch_scc1 L_th4
    s_waitcnt vmcnt(2)
L_th4:
    s_add_u32 s74, s74, s75
    buffer_load_dwordx4 v[192:195], v4, s[4:7], s74 offen offset:0 nt
    s_waitcnt vmcnt(3)
    s_cmp_le_u32 s48, 4
    s_cbranch_scc1 L_th5
    s_waitcnt vmcnt(2)
L_th5:
    buffer_load_dwordx4 v[196:199], v4, s[4:7], s74 offen offset:1024 nt
    buffer_load_dwordx4 v[88:91], v3, s[16:19], s75 offen offset:0 nt
    s_waitcnt vmcnt(4)
    s_cmp_le_u32 s48, 5
    s_cbranch_scc1 L_th6
    s_waitcnt vmcnt(2)
L_th6:
    buffer_load_dwordx4 v[200:203], v4, s[4:7], s74 offen offset:2048 nt
    buffer_load_dwordx4 v[108:111], v54, s[28:31], s81 offen sc1
    s_waitcnt vmcnt(4)
    s_cmp_le_u32 s48, 6
    s_cbranch_scc1 L_th7
    s_waitcnt vmcnt(3)
L_th7:
    buffer_load_dwordx4 v[204:207], v4, s[4:7], s74 offen offset:3072 nt
    buffer_load_dwordx4 v[92:95], v3, s[16:19], s75 offen offset:1024 nt
    s_waitcnt vmcnt(5)
    s_cmp_le_u32 s48, 7
    s_cbranch_scc1 L_th8
    s_waitcnt vmcnt(3)
L_th8:
    s_add_u32 s74, s74, s75
    buffer_load_dwordx4 v[208:211], v4, s[4:7], s74 offen offset:0 nt
    s_waitcnt vmcnt(4)
    buffer_load_dwordx4 v[212:215], v4, s[4:7], s74 offen offset:1024 nt
    s_mov_b32 s83, 0
    buffer_load_dwordx4 v[56:59], v2, s[12:15], s83 offen offset:0 nt
    s_waitcnt vmcnt(4)
    buffer_load_dwordx4 v[216:219], v4, s[4:7], s74 offen offset:2048 nt
    v_bfe_u32 v104, v0, 3, 2
    v_lshrrev_b32 v105, 1, v55
    v_lshl_add_u32 v104, v104, 7, v105
    v_bfe_u32 v105, v0, 5, 1
    v_lshl_add_u32 v104, v105, 2, v104
    v_and_b32 v105, 64, v0
    v_add_u32 v104, v105, v104
    s_mov_b32 s92, 200000
    s_mov_b32 s88, 0x0c0c0400
    s_mov_b32 s89, 0x04000c0c
    s_mov_b32 s90, -1
    s_movk_i32 s91, 0xff00
L_poll:
    v_perm_b32 v106, v109, v108, s88
    v_perm_b32 v107, v111, v110, s89
    v_or_b32 v106, v106, v107
    v_xor_b32 v106, s73, v106
    v_and_b32 v106, s90, v106
    v_cmp_ne_u32 vcc, 0, v106
    s_cbranch_vccz L_polled
    s_sub_u32 s92, s92, 1
    s_cbranch_scc1 L_polled
    s_cmp_gt_u32 s92, 199995
    s_cbranch_scc1 L_reload
    s_cmp_eq_u32 s90, -1
    s_cbranch_scc0 L_flushed
    s_mov_b32 s90, 0xf8ffffff
    s_waitcnt vmcnt(0)
    buffer_wbl2 sc1
    s_waitcnt vmcnt(0)
L_flushed:
    buffer_inv sc1
L_reload:
    buffer_load_dwordx4 v[108:111], v54, s[28:31], s81 offen sc1
    s_waitcnt vmcnt(0)
    s_branch L_poll
L_polled:
    v_and_b32 v108, s91, v108
    v_and_b32 v110, s91, v110
    v_and_b32 v109, s91, v109
    v_and_b32 v111, s91, v111
    v_permlane32_swap_b32 v108, v110
    s_nop 0
    v_permlane32_swap_b32 v109, v111
    v_add_f32 v108, v108, v110
    v_add_f32 v109, v109, v111
    v_cvt_pk_bf16_f32 v108, v108, v109
    v_lshlrev_b32 v112, 16, v108
    v_and_b32 v113, s95, v108
    v_mul_f32 v114, s93, v112
    v_mul_f32 v115, s93, v113
    v_exp_f32 v114, -v114
    v_exp_f32 v115, -v115
    v_add_f32 v114, 1.0, v114
    v_add_f32 v115, 1.0, v115
    v_rcp_f32 v114, v114
    v_rcp_f32 v115, v115
    v_mul_f32 v114, v114, v112
    v_mul_f32 v115, v115, v113
    v_cvt_pk_bf16_f32 v115, v114, v115
    v_lshlrev_b32 v114, 16, v115
    v_and_b32 v115, s95, v115
    s_nop 0
    v_mul_f32_dpp v114, v112, v114 row_ror:8 row_mask:0xf bank_mask:0xf
    v_mul_f32_dpp v115, v113, v115 row_ror:8 row_mask:0xf bank_mask:0xf
    v_cvt_pk_bf16_f32 v114, v114, v115
    s_nop 1
    v_mov_b32_dpp v108, v114 quad_perm:[0,1,2,3] row_mask:0xa bank_mask:0xf
    ds_write_b32 v104, v108 offset:2304
    s_waitcnt vmcnt(3)
    buffer_load_dwordx4 v[220:223], v4, s[4:7], s74 offen offset:3072 nt
    v_add_u32 v36, 1, v123
    s_mov_b32 exec_lo, 0
    s_mov_b32 exec_hi, s49
    buffer_store_dword v36, v122, s[28:31], s50 offen offset:0
    s_mov_b32 exec_lo, 0
    s_mov_b32 exec_hi, -1
    buffer_load_dword v37, v122, s[28:31], s50 offen offset:0 sc1
    s_mov_b64 exec, -1
    buffer_load_dwordx4 v[60:63], v2, s[12:15], s83 offen offset:2048 nt
    v_and_b32 v5, 0xf0, v1
    v_add_u32 v124, 2560, v124
    s_waitcnt lgkmcnt(0)
    s_barrier
    ds_read_b128 v[8:11], v5 offset:2304
    ds_read2_b32 v[48:49], v124 offset0:0 offset1:8
    ds_read2_b32 v[50:51], v124 offset0:16 offset1:24
    ds_read_b64 v[120:121], v116 offset:2816
    s_waitcnt vmcnt(6)
    s_add_u32 s74, s74, s75
    buffer_load_dwordx4 v[224:227], v4, s[4:7], s74 offen offset:0 nt
    s_cmp_lg_u32 s3, 0
    s_cbranch_scc1 L_nobump
    v_mov_b32 v104, s98
    s_mov_b64 exec, 1
    buffer_store_dword v104, v116, s[28:31], s100 offen
    s_mov_b64 exec, -1
L_nobump:
    s_waitcnt lgkmcnt(0)
L_synced:
    v_dot2_f32_bf16 v24, v128, v8, 0
    v_dot2_f32_bf16 v25, v132, v8, 0
    v_dot2_f32_bf16 v26, v136, v8, 0
    v_dot2_f32_bf16 v27, v140, v8, 0
    v_dot2c_f32_bf16 v24, v129, v9
    v_dot2c_f32_bf16 v25, v133, v9
    v_dot2c_f32_bf16 v26, v137, v9
    v_dot2c_f32_bf16 v27, v141, v9
    v_dot2c_f32_bf16 v24, v130, v10
    v_dot2c_f32_bf16 v25, v134, v10
    v_dot2c_f32_bf16 v26, v138, v10
    v_dot2c_f32_bf16 v27, v142, v10
    v_dot2c_f32_bf16 v24, v131, v11
    v_dot2c_f32_bf16 v26, v139, v11
    v_dot2c_f32_bf16 v25, v135, v11
    v_dot2c_f32_bf16 v27, v143, v11
    v_add_f32_dpp v28, v24, v24 row_ror:8 row_mask:0xf bank_mask:0x3
    v_add_f32_dpp v29, v26, v26 row_ror:8 row_mask:0xf bank_mask:0x3
    s_nop 0
    v_add_f32_dpp v28, v25, v25 row_ror:8 row_mask:0xf bank_mask:0xc
    v_add_f32_dpp v29, v27, v27 row_ror:8 row_mask:0xf bank_mask:0xc
    s_nop 0
    v_add_f32_dpp v16, v28, v28 row_half_mirror row_mask:0xf bank_mask:0x5
    s_nop 1
    v_add_f32_dpp v16, v29, v29 row_half_mirror row_mask:0xf bank_mask:0xa
    s_nop 1
    v_add_f32_dpp v16, v16, v16 quad_perm:[1,0,3,2] row_mask:0xf bank_mask:0xf
    s_nop 1
    v_add_f32_dpp v16, v16, v16 quad_perm:[2,3,0,1] row_mask:0xf bank_mask:0xf
    s_cmp_lg_u32 s101, 9
    s_cbranch_scc1 L_noflag
    v_mov_b32 v105, 1
    s_and_b32 s86, s2, 7
    s_lshl_b32 s86, s86, 5
    s_mov_b64 exec, 1
    buffer_store_dword v105, v116, s[32:35], s86 offen sc1
    s_mov_b64 exec, -1
L_noflag:
    s_waitcnt vmcnt(5)
    buffer_load_dwordx4 v[228:231], v4, s[4:7], s74 offen offset:1024 nt
    v_dot2_f32_bf16 v24, v144, v8, 0
    v_dot2_f32_bf16 v25, v148, v8, 0
    v_dot2_f32_bf16 v26, v152, v8, 0
    v_dot2_f32_bf16 v27, v156, v8, 0
    v_dot2c_f32_bf16 v24, v145, v9
    v_dot2c_f32_bf16 v25, v149, v9
    v_dot2c_f32_bf16 v26, v153, v9
    v_dot2c_f32_bf16 v27, v157, v9
    v_dot2c_f32_bf16 v24, v146, v10
    v_dot2c_f32_bf16 v25, v150, v10
    v_dot2c_f32_bf16 v26, v154, v10
    v_dot2c_f32_bf16 v27, v158, v10
    v_dot2c_f32_bf16 v24, v147, v11
    v_dot2c_f32_bf16 v26, v155, v11
    v_dot2c_f32_bf16 v25, v151, v11
    v_dot2c_f32_bf16 v27, v159, v11
    v_add_f32_dpp v28, v24, v24 row_ror:8 row_mask:0xf bank_mask:0x3
    v_add_f32_dpp v29, v26, v26 row_ror:8 row_mask:0xf bank_mask:0x3
    s_nop 0
    v_add_f32_dpp v28, v25, v25 row_ror:8 row_mask:0xf bank_mask:0xc
    v_add_f32_dpp v29, v27, v27 row_ror:8 row_mask:0xf bank_mask:0xc
    s_nop 0
    v_add_f32_dpp v17, v28, v28 row_half_mirror row_mask:0xf bank_mask:0x5
    s_nop 1
    v_add_f32_dpp v17, v29, v29 row_half_mirror row_mask:0xf bank_mask:0xa
    s_nop 1
    v_add_f32_dpp v17, v17, v17 quad_perm:[1,0,3,2] row_mask:0xf bank_mask:0xf
    s_nop 1
    v_add_f32_dpp v17, v17, v17 quad_perm:[2,3,0,1] row_mask:0xf bank_mask:0xf
    v_cvt_pk_bf16_f32 v28, v16, v17
    v_lshlrev_b32 v16, 16, v28
    v_and_b32 v17, s95, v28
    v_mul_f32 v16, s94, v16
    v_mul_f32 v17, s94, v17
    v_cvt_pk_bf16_f32 v28, v16, v17
    v_lshlrev_b32 v16, 16, v28
    v_and_b32 v17, s95, v28
    s_waitcnt vmcnt(5)
    buffer_load_dwordx4 v[232:235], v4, s[4:7], s74 offen offset:2048 nt
    v_dot2_f32_bf16 v24, v160, v8, 0
    v_dot2_f32_bf16 v25, v164, v8, 0
    v_dot2_f32_bf16 v26, v168, v8, 0
    v_dot2_f32_bf16 v27, v172, v8, 0
    v_dot2c_f32_bf16 v24, v161, v9
    v_dot2c_f32_bf16 v25, v165, v9
    v_dot2c_f32_bf16 v26, v169, v9
    v_dot2c_f32_bf16 v27, v173, v9
    v_dot2c_f32_bf16 v24, v162, v10
    v_dot2c_f32_bf16 v25, v166, v10
    v_dot2c_f32_bf16 v26, v170, v10
    v_dot2c_f32_bf16 v27, v174, v10
    v_dot2c_f32_bf16 v24, v163, v11
    v_dot2c_f32_bf16 v26, v171, v11
    v_dot2c_f32_bf16 v25, v167, v11
    v_dot2c_f32_bf16 v27, v175, v11
    v_add_f32_dpp v28, v24, v24 row_ror:8 row_mask:0xf bank_mask:0x3
    v_add_f32_dpp v29, v26, v26 row_ror:8 row_mask:0xf bank_mask:0x3
    s_nop 0
    v_add_f32_dpp v28, v25, v25 row_ror:8 row_mask:0xf bank_mask:0xc
    v_add_f32_dpp v29, v27, v27 row_ror:8 row_mask:0xf bank_mask:0xc
    s_nop 0
    v_add_f32_dpp v18, v28, v28 row_half_mirror row_mask:0xf bank_mask:0x5
    s_nop 1
    v_add_f32_dpp v18, v29, v29 row_half_mirror row_mask:0xf bank_mask:0xa
    s_nop 1
    v_add_f32_dpp v18, v18, v18 quad_perm:[1,0,3,2] row_mask:0xf bank_mask:0xf
    s_nop 1
    v_add_f32_dpp v18, v18, v18 quad_perm:[2,3,0,1] row_mask:0xf bank_mask:0xf
    s_add_u32 s83, s83, s84
    buffer_load_dwordx4 v[64:67], v2, s[12:15], s83 offen offset:0 nt
    s_waitcnt vmcnt(3)
    buffer_load_dwordx4 v[236:239], v4, s[4:7], s74 offen offset:3072 nt
    v_cmp_ne_u32 vcc, v37, v123
    s_bcnt1_i32_b32 s48, vcc_hi
    s_sub_i32 s48, 32, s48
    s_max_i32 s48, s48, 0
    s_mul_i32 s48, s48, 2
    s_lshr_b32 s48, s48, 3
    v_dot2_f32_bf16 v24, v176, v8, 0
    v_dot2_f32_bf16 v25, v180, v8, 0
    v_dot2_f32_bf16 v26, v184, v8, 0
    v_dot2_f32_bf16 v27, v188, v8, 0
    v_dot2c_f32_bf16 v24, v177, v9
    v_dot2c_f32_bf16 v25, v181, v9
    v_dot2c_f32_bf16 v26, v185, v9
    v_dot2c_f32_bf16 v27, v189, v9
    v_dot2c_f32_bf16 v24, v178, v10
    v_dot2c_f32_bf16 v25, v182, v10
    v_dot2c_f32_bf16 v26, v186, v10
    v_dot2c_f32_bf16 v27, v190, v10
    v_dot2c_f32_bf16 v24, v179, v11
    v_dot2c_f32_bf16 v26, v187, v11
    v_dot2c_f32_bf16 v25, v183, v11
    v_dot2c_f32_bf16 v27, v191, v11
    v_add_f32_dpp v28, v24, v24 row_ror:8 row_mask:0xf bank_mask:0x3
    v_add_f32_dpp v29, v26, v26 row_ror:8 row_mask:0xf bank_mask:0x3
    s_nop 0
    v_add_f32_dpp v28, v25, v25 row_ror:8 row_mask:0xf bank_mask:0xc
    v_add_f32_dpp v29, v27, v27 row_ror:8 row_mask:0xf bank_mask:0xc
    s_nop 0
    v_add_f32_dpp v19, v28, v28 row_half_mirror row_mask:0xf bank_mask:0x5
    s_nop 1
    v_add_f32_dpp v19, v29, v29 row_half_mirror row_mask:0xf bank_mask:0xa
    s_nop 1
    v_add_f32_dpp v19, v19, v19 quad_perm:[1,0,3,2] row_mask:0xf bank_mask:0xf
    s_nop 1
    v_add_f32_dpp v19, v19, v19 quad_perm:[2,3,0,1] row_mask:0xf bank_mask:0xf
    v_cvt_pk_bf16_f32 v28, v18, v19
    v_lshlrev_b32 v18, 16, v28
    v_and_b32 v19, s95, v28
    v_mul_f32 v18, s94, v18
    v_mul_f32 v19, s94, v19
    v_cvt_pk_bf16_f32 v28, v18, v19
    v_lshlrev_b32 v18, 16, v28
    v_and_b32 v19, s95, v28
    s_waitcnt vmcnt(3)
    s_cmp_le_u32 s48, 0
    s_cbranch_scc1 L_th9
    s_waitcnt vmcnt(2)
L_th9:
    s_add_u32 s74, s74, s75
    buffer_load_dwordx4 v[240:243], v4, s[4:7], s74 offen offset:0 nt
    v_dot2_f32_bf16 v24, v192, v8, 0
    v_dot2_f32_bf16 v25, v196, v8, 0
    v_dot2_f32_bf16 v26, v200, v8, 0
    v_dot2_f32_bf16 v27, v204, v8, 0
    v_dot2c_f32_bf16 v24, v193, v9
    v_dot2c_f32_bf16 v25, v197, v9
    v_dot2c_f32_bf16 v26, v201, v9
    v_dot2c_f32_bf16 v27, v205, v9
    v_dot2c_f32_bf16 v24, v194, v10
    v_dot2c_f32_bf16 v25, v198, v10
    v_dot2c_f32_bf16 v26, v202, v10
    v_dot2c_f32_bf16 v27, v206, v10
    v_dot2c_f32_bf16 v24, v195, v11
    v_dot2c_f32_bf16 v26, v203, v11
    v_dot2c_f32_bf16 v25, v199, v11
    v_dot2c_f32_bf16 v27, v207, v11
    v_add_f32_dpp v28, v24, v24 row_ror:8 row_mask:0xf bank_mask:0x3
    v_add_f32_dpp v29, v26, v26 row_ror:8 row_mask:0xf bank_mask:0x3
    s_nop 0
    v_add_f32_dpp v28, v25, v25 row_ror:8 row_mask:0xf bank_mask:0xc
    v_add_f32_dpp v29, v27, v27 row_ror:8 row_mask:0xf bank_mask:0xc
    s_nop 0
    v_add_f32_dpp v20, v28, v28 row_half_mirror row_mask:0xf bank_mask:0x5
    s_nop 1
    v_add_f32_dpp v20, v29, v29 row_half_mirror row_mask:0xf bank_mask:0xa
    s_nop 1
    v_add_f32_dpp v20, v20, v20 quad_perm:[1,0,3,2] row_mask:0xf bank_mask:0xf
    s_nop 1
    v_add_f32_dpp v20, v20, v20 quad_perm:[2,3,0,1] row_mask:0xf bank_mask:0xf
    s_waitcnt vmcnt(3)
    s_cmp_le_u32 s48, 1
    s_cbranch_scc1 L_th10
    s_waitcnt vmcnt(1)
L_th10:
    buffer_load_dwordx4 v[244:247], v4, s[4:7], s74 offen offset:1024 nt
    v_dot2_f32_bf16 v24, v208, v8, 0
    v_dot2_f32_bf16 v25, v212, v8, 0
    v_dot2_f32_bf16 v26, v216, v8, 0
    v_dot2_f32_bf16 v27, v220, v8, 0
    v_dot2c_f32_bf16 v24, v209, v9
    v_dot2c_f32_bf16 v25, v213, v9
    v_dot2c_f32_bf16 v26, v217, v9
    v_dot2c_f32_bf16 v27, v221, v9
    v_dot2c_f32_bf16 v24, v210, v10
    v_dot2c_f32_bf16 v25, v214, v10
    v_dot2c_f32_bf16 v26, v218, v10
    v_dot2c_f32_bf16 v27, v222, v10
    v_dot2c_f32_bf16 v24, v211, v11
    v_dot2c_f32_bf16 v26, v219, v11
    v_dot2c_f32_bf16 v25, v215, v11
    v_dot2c_f32_bf16 v27, v223, v11
    v_add_f32_dpp v28, v24, v24 row_ror:8 row_mask:0xf bank_mask:0x3
    v_add_f32_dpp v29, v26, v26 row_ror:8 row_mask:0xf bank_mask:0x3
    s_nop 0
    v_add_f32_dpp v28, v25, v25 row_ror:8 row_mask:0xf bank_mask:0xc
    v_add_f32_dpp v29, v27, v27 row_ror:8 row_mask:0xf bank_mask:0xc
    s_nop 0
    v_add_f32_dpp v21, v28, v28 row_half_mirror row_mask:0xf bank_mask:0x5
    s_nop 1
    v_add_f32_dpp v21, v29, v29 row_half_mirror row_mask:0xf bank_mask:0xa
    s_nop 1
    v_add_f32_dpp v21, v21, v21 quad_perm:[1,0,3,2] row_mask:0xf bank_mask:0xf
    s_nop 1
    v_add_f32_dpp v21, v21, v21 quad_perm:[2,3,0,1] row_mask:0xf bank_mask:0xf
    v_cvt_pk_bf16_f32 v28, v20, v21
    v_lshlrev_b32 v20, 16, v28
    v_and_b32 v21, s95, v28
    v_mul_f32 v20, s94, v20
    v_mul_f32 v21, s94, v21
    v_cvt_pk_bf16_f32 v28, v20, v21
    v_lshlrev_b32 v20, 16, v28
    v_and_b32 v21, s95, v28
    buffer_load_dwordx4 v[68:71], v2, s[12:15], s83 offen offset:2048 nt
    s_waitcnt vmcnt(3)
    s_cmp_le_u32 s48, 2
    s_cbranch_scc1 L_th11
    s_waitcnt vmcnt(2)
L_th11:
    buffer_load_dwordx4 v[248:251], v4, s[4:7], s74 offen offset:2048 nt
    v_dot2_f32_bf16 v24, v224, v8, 0
    v_dot2_f32_bf16 v25, v228, v8, 0
    v_dot2_f32_bf16 v26, v232, v8, 0
    v_dot2_f32_bf16 v27, v236, v8, 0
    v_dot2c_f32_bf16 v24, v225, v9
    v_dot2c_f32_bf16 v25, v229, v9
    v_dot2c_f32_bf16 v26, v233, v9
    v_dot2c_f32_bf16 v27, v237, v9
    v_dot2c_f32_bf16 v24, v226, v10
    v_dot2c_f32_bf16 v25, v230, v10
    v_dot2c_f32_bf16 v26, v234, v10
    v_dot2c_f32_bf16 v27, v238, v10
    v_dot2c_f32_bf16 v24, v227, v11
    v_dot2c_f32_bf16 v26, v235, v11
    v_dot2c_f32_bf16 v25, v231, v11
    v_dot2c_f32_bf16 v27, v239, v11
    v_add_f32_dpp v28, v24, v24 row_ror:8 row_mask:0xf bank_mask:0x3
    v_add_f32_dpp v29, v26, v26 row_ror:8 row_mask:0xf bank_mask:0x3
    s_nop 0
    v_add_f32_dpp v28, v25, v25 row_ror:8 row_mask:0xf bank_mask:0xc
    v_add_f32_dpp v29, v27, v27 row_ror:8 row_mask:0xf bank_mask:0xc
    s_nop 0
    v_add_f32_dpp v22, v28, v28 row_half_mirror row_mask:0xf bank_mask:0x5
    s_nop 1
    v_add_f32_dpp v22, v29, v29 row_half_mirror row_mask:0xf bank_mask:0xa
    s_nop 1
    v_add_f32_dpp v22, v22, v22 quad_perm:[1,0,3,2] row_mask:0xf bank_mask:0xf
    s_nop 1
    v_add_f32_dpp v22, v22, v22 quad_perm:[2,3,0,1] row_mask:0xf bank_mask:0xf
    s_waitcnt vmcnt(3)
    s_cmp_le_u32 s48, 3
    s_cbranch_scc1 L_th12
    s_waitcnt vmcnt(2)
L_th12:
    buffer_load_dwordx4 v[252:255], v4, s[4:7], s74 offen offset:3072 nt
    s_waitcnt vmcnt(3)
    s_cmp_le_u32 s48, 4
    s_cbranch_scc1 L_th13
    s_waitcnt vmcnt(1)
L_th13:
    s_mov_b32 s74, s57
    buffer_load_dwordx4 v[128:131], v4, s[8:11], s74 offen offset:0 nt
    s_add_u32 s83, s83, s84
    buffer_load_dwordx4 v[96:99], v2, s[12:15], s83 offen offset:0 nt
    s_waitcnt vmcnt(3)
    s_cmp_le_u32 s48, 5
    s_cbranch_scc1 L_th14
    s_waitcnt vmcnt(2)
L_th14:
    buffer_load_dwordx4 v[132:135], v4, s[8:11], s74 offen offset:1024 nt
    s_waitcnt vmcnt(3)
    s_cmp_le_u32 s48, 6
    s_cbranch_scc1 L_th15
    s_waitcnt vmcnt(2)
L_th15:
    buffer_load_dwordx4 v[136:139], v4, s[8:11], s74 offen offset:2048 nt
    v_dot2_f32_bf16 v24, v240, v8, 0
    v_dot2_f32_bf16 v25, v244, v8, 0
    v_dot2_f32_bf16 v26, v248, v8, 0
    v_dot2_f32_bf16 v27, v252, v8, 0
    v_dot2c_f32_bf16 v24, v241, v9
    v_dot2c_f32_bf16 v25, v245, v9
    v_dot2c_f32_bf16 v26, v249, v9
    v_dot2c_f32_bf16 v27, v253, v9
    v_dot2c_f32_bf16 v24, v242, v10
    v_dot2c_f32_bf16 v25, v246, v10
    v_dot2c_f32_bf16 v26, v250, v10
    v_dot2c_f32_bf16 v27, v254, v10
    v_dot2c_f32_bf16 v24, v243, v11
    v_dot2c_f32_bf16 v26, v251, v11
    v_dot2c_f32_bf16 v25, v247, v11
    v_dot2c_f32_bf16 v27, v255, v11
    v_add_f32_dpp v28, v24, v24 row_ror:8 row_mask:0xf bank_mask:0x3
    v_add_f32_dpp v29, v26, v26 row_ror:8 row_mask:0xf bank_mask:0x3
    s_nop 0
    v_add_f32_dpp v28, v25, v25 row_ror:8 row_mask:0xf bank_mask:0xc
    v_add_f32_dpp v29, v27, v27 row_ror:8 row_mask:0xf bank_mask:0xc
    s_nop 0
    v_add_f32_dpp v23, v28, v28 row_half_mirror row_mask:0xf bank_mask:0x5
    s_nop 1
    v_add_f32_dpp v23, v29, v29 row_half_mirror row_mask:0xf bank_mask:0xa
    s_nop 1
    v_add_f32_dpp v23, v23, v23 quad_perm:[1,0,3,2] row_mask:0xf bank_mask:0xf
    s_nop 1
    v_add_f32_dpp v23, v23, v23 quad_perm:[2,3,0,1] row_mask:0xf bank_mask:0xf
    v_cvt_pk_bf16_f32 v28, v22, v23
    v_lshlrev_b32 v22, 16, v28
    v_and_b32 v23, s95, v28
    v_mul_f32 v22, s94, v22
    v_mul_f32 v23, s94, v23
    v_cvt_pk_bf16_f32 v28, v22, v23
    v_lshlrev_b32 v22, 16, v28
    v_and_b32 v23, s95, v28
    buffer_load_dwordx4 v[100:103], v2, s[12:15], s83 offen offset:2048 nt
    v_max3_f32 v28, v16, v17, v18
    v_max3_f32 v28, v28, v19, v20
    v_max3_f32 v28, v28, v21, v22
    v_max_f32 v28, v28, v23
    s_nop 1
    v_max_f32_dpp v28, v28, v28 row_ror:4 row_mask:0xf bank_mask:0xf
    s_nop 1
    v_max_f32_dpp v28, v28, v28 row_ror:8 row_mask:0xf bank_mask:0xf
    v_mov_b32 v24, v28
    s_nop 1
    v_permlane16_swap_b32 v28, v24
    v_max_f32 v28, v28, v24
    v_mov_b32 v24, v28
    s_nop 1
    v_permlane32_swap_b32 v28, v24
    v_max_f32 v28, v28, v24
    v_mul_f32 v28, s93, v28
    v_fma_f32 v16, v16, s93, -v28
    v_fma_f32 v17, v17, s93, -v28
    v_fma_f32 v18, v18, s93, -v28
    v_fma_f32 v19, v19, s93, -v28
    v_fma_f32 v20, v20, s93, -v28
    v_fma_f32 v21, v21, s93, -v28
    v_fma_f32 v22, v22, s93, -v28
    v_fma_f32 v23, v23, s93, -v28
    s_waitcnt vmcnt(4)
    s_cmp_le_u32 s48, 7
    s_cbranch_scc1 L_th16
    s_waitcnt vmcnt(2)
L_th16:
    buffer_load_dwordx4 v[140:143], v4, s[8:11], s74 offen offset:3072 nt
    v_exp_f32 v16, v16
    v_exp_f32 v17, v17
    v_exp_f32 v18, v18
    v_exp_f32 v19, v19
    v_exp_f32 v20, v20
    v_exp_f32 v21, v21
    v_exp_f32 v22, v22
    v_exp_f32 v23, v23
    v_add_f32 v29, v16, v17
    v_add_f32 v29, v29, v18
    v_add_f32 v29, v29, v19
    v_add_f32 v29, v29, v20
    v_add_f32 v29, v29, v21
    v_add_f32 v29, v29, v22
    v_add_f32 v29, v29, v23
    v_cvt_pk_bf16_f32 v16, v16, v16
    v_cvt_pk_bf16_f32 v17, v17, v17
    v_cvt_pk_bf16_f32 v18, v18, v18
    v_cvt_pk_bf16_f32 v19, v19, v19
    v_cvt_pk_bf16_f32 v20, v20, v20
    v_cvt_pk_bf16_f32 v21, v21, v21
    v_cvt_pk_bf16_f32 v22, v22, v22
    v_cvt_pk_bf16_f32 v23, v23, v23
    v_and_b32 v40, v16, v12
    v_and_b32 v41, v16, v13
    v_and_b32_dpp v42, v16, v14 row_half_mirror row_mask:0xf bank_mask:0xf
    v_and_b32_dpp v43, v16, v15 row_half_mirror row_mask:0xf bank_mask:0xf
    v_and_b32_dpp v44, v16, v12 row_half_mirror row_mask:0xf bank_mask:0xf
    v_and_b32_dpp v45, v16, v13 row_half_mirror row_mask:0xf bank_mask:0xf
    v_and_b32 v46, v16, v14
    v_and_b32 v47, v16, v15
    v_mfma_f32_16x16x32_bf16 v[32:35], v[40:43], v[128:131], 0
    v_perm_b32 v160, v60, v56, s46
    v_perm_b32 v164, v60, v56, s47
    v_perm_b32 v168, v61, v57, s46
    v_perm_b32 v172, v61, v57, s47
    v_perm_b32 v176, v62, v58, s46
    v_perm_b32 v180, v62, v58, s47
    v_perm_b32 v184, v63, v59, s46
    v_perm_b32 v188, v63, v59, s47
    s_waitcnt vmcnt(3)
    s_add_u32 s74, s74, s75
    buffer_load_dwordx4 v[144:147], v4, s[8:11], s74 offen offset:0 nt
    v_add_f32_dpp v29, v29, v29 row_ror:4 row_mask:0xf bank_mask:0xf
    s_nop 1
    v_add_f32_dpp v29, v29, v29 row_ror:8 row_mask:0xf bank_mask:0xf
    v_mov_b32 v24, v29
    s_nop 1
    v_permlane16_swap_b32 v29, v24
    v_add_f32 v29, v29, v24
    v_mov_b32 v24, v29
    s_nop 1
    v_permlane32_swap_b32 v29, v24
    v_add_f32 v29, v29, v24
    s_lshl_b32 s88, s3, 3
    v_mov_b32 v24, s88
    v_mov_b32 v53, v28
    ds_write_b64 v24, v[28:29] offset:2848
    s_lshl_b32 s99, s44, 5
    s_load_dword s98, s[32:33], s99
    v_mfma_f32_16x16x32_bf16 v[36:39], v[40:43], v[132:135], 0
    v_and_b32 v40, v17, v12
    v_and_b32 v41, v17, v13
    v_and_b32_dpp v42, v17, v14 row_half_mirror row_mask:0xf bank_mask:0xf
    v_and_b32_dpp v43, v17, v15 row_half_mirror row_mask:0xf bank_mask:0xf
    v_perm_b32 v161, v68, v64, s46
    v_perm_b32 v165, v68, v64, s47
    v_perm_b32 v169, v69, v65, s46
    v_perm_b32 v173, v69, v65, s47
    v_perm_b32 v177, v70, v66, s46
    v_perm_b32 v181, v70, v66, s47
    v_perm_b32 v185, v71, v67, s46
    v_perm_b32 v189, v71, v67, s47
    s_waitcnt vmcnt(3)
    buffer_load_dwordx4 v[148:151], v4, s[8:11], s74 offen offset:1024 nt
    v_add_u32 v54, 1, v125
    s_mov_b32 exec_lo, s49
    s_mov_b32 exec_hi, 0
    buffer_store_dword v54, v122, s[28:31], s50 offen offset:256
    s_mov_b32 exec_lo, -1
    s_mov_b32 exec_hi, 0
    buffer_load_dword v55, v122, s[28:31], s50 offen offset:256 sc1
    s_mov_b64 exec, -1
    v_mfma_f32_16x16x32_bf16 v[32:35], v[44:47], v[136:139], v[32:35]
    v_mov_b32 v107, 0
    v_mov_b32 v111, 0
    v_perm_b32 v104, v76, v72, s46
    v_perm_b32 v105, v84, v80, s46
    v_perm_b32 v106, v92, v88, s46
    v_perm_b32 v108, v76, v72, s47
    v_perm_b32 v109, v84, v80, s47
    v_perm_b32 v110, v92, v88, s47
    v_mfma_f32_16x16x32_bf16 v[112:115], v[48:51], v[104:107], 0
    s_nop 0
    v_mfma_f32_16x16x32_bf16 v[116:119], v[48:51], v[108:111], 0
    s_add_u32 s83, s83, s84
    buffer_load_dwordx4 v[224:227], v2, s[12:15], s83 offen offset:0 nt
    s_nop 3
    v_add_f32_dpp v30, v113, v112 row_ror:8 row_mask:0x1 bank_mask:0x3
    s_nop 1
    v_add_f32_dpp v30, v117, v116 row_ror:8 row_mask:0x2 bank_mask:0x3
    s_waitcnt vmcnt(5)
    buffer_load_dwordx4 v[152:155], v4, s[8:11], s74 offen offset:2048 nt
    v_mfma_f32_16x16x32_bf16 v[36:39], v[44:47], v[140:143], v[36:39]
    v_and_b32_dpp v44, v17, v12 row_half_mirror row_mask:0xf bank_mask:0xf
    v_and_b32_dpp v45, v17, v13 row_half_mirror row_mask:0xf bank_mask:0xf
    v_and_b32 v46, v17, v14
    v_and_b32 v47, v17, v15
    v_perm_b32 v162, v100, v96, s46
    v_perm_b32 v166, v100, v96, s47
    v_perm_b32 v170, v101, v97, s46
    v_perm_b32 v174, v101, v97, s47
    v_perm_b32 v178, v102, v98, s46
    v_perm_b32 v182, v102, v98, s47
    v_perm_b32 v186, v103, v99, s46
    v_perm_b32 v190, v103, v99, s47
    s_waitcnt vmcnt(5)
    buffer_load_dwordx4 v[156:159], v4, s[8:11], s74 offen offset:3072 nt
    v_mfma_f32_16x16x32_bf16 v[32:35], v[40:43], v[144:147], v[32:35]
    v_perm_b32 v104, v77, v73, s46
    v_perm_b32 v105, v85, v81, s46
    v_perm_b32 v106, v93, v89, s46
    v_perm_b32 v108, v77, v73, s47
    v_perm_b32 v109, v85, v81, s47
    v_perm_b32 v110, v93, v89, s47
    v_mfma_f32_16x16x32_bf16 v[112:115], v[48:51], v[104:107], 0
    s_nop 0
    v_mfma_f32_16x16x32_bf16 v[116:119], v[48:51], v[108:111], 0
    buffer_load_dwordx4 v[228:231], v2, s[12:15], s83 offen offset:2048 nt
    s_nop 4
    v_add_f32_dpp v30, v113, v112 row_ror:8 row_mask:0x4 bank_mask:0x3
    s_nop 1
    v_add_f32_dpp v30, v117, v116 row_ror:8 row_mask:0x8 bank_mask:0x3
    s_waitcnt vmcnt(6)
    s_add_u32 s74, s74, s75
    buffer_load_dwordx4 v[128:131], v4, s[8:11], s74 offen offset:0 nt
    v_mfma_f32_16x16x32_bf16 v[36:39], v[40:43], v[148:151], v[36:39]
    v_and_b32 v40, v18, v12
    v_and_b32 v41, v18, v13
    v_and_b32_dpp v42, v18, v14 row_half_mirror row_mask:0xf bank_mask:0xf
    v_and_b32_dpp v43, v18, v15 row_half_mirror row_mask:0xf bank_mask:0xf
    v_perm_b32 v104, v78, v74, s46
    v_perm_b32 v105, v86, v82, s46
    v_perm_b32 v106, v94, v90, s46
    v_perm_b32 v108, v78, v74, s47
    v_perm_b32 v109, v86, v82, s47
    v_perm_b32 v110, v94, v90, s47
    v_mfma_f32_16x16x32_bf16 v[112:115], v[48:51], v[104:107], 0
    s_nop 0
    v_mfma_f32_16x16x32_bf16 v[116:119], v[48:51], v[108:111], 0
    s_waitcnt vmcnt(3)
    buffer_load_dwordx4 v[132:135], v4, s[8:11], s74 offen offset:1024 nt
    v_cmp_ne_u32 vcc, v55, v125
    s_bcnt1_i32_b32 s48, vcc_lo
    s_sub_i32 s48, 32, s48
    s_max_i32 s48, s48, 0
    s_mul_i32 s48, s48, 2
    s_lshr_b32 s48, s48, 3
    v_mfma_f32_16x16x32_bf16 v[32:35], v[44:47], v[152:155], v[32:35]
    v_add_f32_dpp v31, v113, v112 row_ror:8 row_mask:0x1 bank_mask:0x3
    s_nop 1
    v_add_f32_dpp v31, v117, v116 row_ror:8 row_mask:0x2 bank_mask:0x3
    s_add_u32 s83, s83, s84
    buffer_load_dwordx4 v[232:235], v2, s[12:15], s83 offen offset:0 nt
    v_perm_b32 v104, v79, v75, s46
    v_perm_b32 v105, v87, v83, s46
    v_perm_b32 v106, v95, v91, s46
    v_perm_b32 v108, v79, v75, s47
    v_perm_b32 v109, v87, v83, s47
    v_perm_b32 v110, v95, v91, s47
    v_mfma_f32_16x16x32_bf16 v[112:115], v[48:51], v[104:107], 0
    s_nop 0
    v_mfma_f32_16x16x32_bf16 v[116:119], v[48:51], v[108:111], 0
    s_waitcnt vmcnt(4)
    s_cmp_le_u32 s48, 0
    s_cbranch_scc1 L_th17
    s_waitcnt vmcnt(2)
L_th17:
    buffer_load_dwordx4 v[136:139], v4, s[8:11], s74 offen offset:2048 nt
    v_mfma_f32_16x16x32_bf16 v[36:39], v[44:47], v[156:159], v[36:39]
    v_and_b32_dpp v44, v18, v12 row_half_mirror row_mask:0xf bank_mask:0xf
    v_and_b32_dpp v45, v18, v13 row_half_mirror row_mask:0xf bank_mask:0xf
    v_and_b32 v46, v18, v14
    v_and_b32 v47, v18, v15
    v_add_f32_dpp v31, v113, v112 row_ror:8 row_mask:0x4 bank_mask:0x3
    s_nop 1
    v_add_f32_dpp v31, v117, v116 row_ror:8 row_mask:0x8 bank_mask:0x3
    v_mul_f32_dpp v30, v30, v121 quad_perm:[0,1,2,3] row_mask:0xf bank_mask:0x3
    s_nop 0
    v_mul_f32_dpp v31, v31, v121 quad_perm:[0,1,2,3] row_mask:0xf bank_mask:0x3
    s_waitcnt vmcnt(3)
    s_cmp_le_u32 s48, 1
    s_cbranch_scc1 L_th18
    s_waitcnt vmcnt(2)
L_th18:
    buffer_load_dwordx4 v[140:143], v4, s[8:11], s74 offen offset:3072 nt
    v_mfma_f32_16x16x32_bf16 v[32:35], v[40:43], v[128:131], v[32:35]
    v_perm_b32 v163, v228, v224, s46
    v_perm_b32 v167, v228, v224, s47
    v_perm_b32 v171, v229, v225, s46
    v_perm_b32 v175, v229, v225, s47
    v_perm_b32 v179, v230, v226, s46
    v_perm_b32 v183, v230, v226, s47
    v_perm_b32 v187, v231, v227, s46
    v_perm_b32 v191, v231, v227, s47
    buffer_load_dwordx4 v[236:239], v2, s[12:15], s83 offen offset:2048 nt
    s_waitcnt vmcnt(4)
    s_cmp_le_u32 s48, 2
    s_cbranch_scc1 L_th19
    s_waitcnt vmcnt(2)
L_th19:
    s_add_u32 s74, s74, s75
    buffer_load_dwordx4 v[144:147], v4, s[8:11], s74 offen offset:0 nt
    v_mfma_f32_16x16x32_bf16 v[36:39], v[40:43], v[132:135], v[36:39]
    v_and_b32 v40, v19, v12
    v_and_b32 v41, v19, v13
    v_and_b32_dpp v42, v19, v14 row_half_mirror row_mask:0xf bank_mask:0xf
    v_and_b32_dpp v43, v19, v15 row_half_mirror row_mask:0xf bank_mask:0xf
    s_waitcnt vmcnt(3)
    s_cmp_le_u32 s48, 3
    s_cbranch_scc1 L_th20
    s_waitcnt vmcnt(2)
L_th20:
    buffer_load_dwordx4 v[148:151], v4, s[8:11], s74 offen offset:1024 nt
    v_mfma_f32_16x16x32_bf16 v[32:35], v[44:47], v[136:139], v[32:35]
    s_waitcnt vmcnt(3)
    s_cmp_le_u32 s48, 4
    s_cbranch_scc1 L_th21
    s_waitcnt vmcnt(1)
L_th21:
    buffer_load_dwordx4 v[152:155], v4, s[8:11], s74 offen offset:2048 nt
    v_mfma_f32_16x16x32_bf16 v[36:39], v[44:47], v[140:143], v[36:39]
    v_and_b32_dpp v44, v19, v12 row_half_mirror row_mask:0xf bank_mask:0xf
    v_and_b32_dpp v45, v19, v13 row_half_mirror row_mask:0xf bank_mask:0xf
    v_and_b32 v46, v19, v14
    v_and_b32 v47, v19, v15
    s_add_u32 s83, s83, s84
    buffer_load_dwordx4 v[240:243], v2, s[12:15], s83 offen offset:0 nt
    s_waitcnt vmcnt(3)
    s_cmp_le_u32 s48, 5
    s_cbranch_scc1 L_th22
    s_waitcnt vmcnt(2)
L_th22:
    buffer_load_dwordx4 v[156:159], v4, s[8:11], s74 offen offset:3072 nt
    v_mfma_f32_16x16x32_bf16 v[32:35], v[40:43], v[144:147], v[32:35]
    v_perm_b32 v192, v236, v232, s46
    v_perm_b32 v196, v236, v232, s47
    v_perm_b32 v200, v237, v233, s46
    v_perm_b32 v204, v237, v233, s47
    v_perm_b32 v208, v238, v234, s46
    v_perm_b32 v212, v238, v234, s47
    v_perm_b32 v216, v239, v235, s46
    v_perm_b32 v220, v239, v235, s47
    s_waitcnt vmcnt(3)
    s_cmp_le_u32 s48, 6
    s_cbranch_scc1 L_th23
    s_waitcnt vmcnt(2)
L_th23:
    s_add_u32 s74, s74, s75
    buffer_load_dwordx4 v[128:131], v4, s[8:11], s74 offen offset:0 nt
    v_mfma_f32_16x16x32_bf16 v[36:39], v[40:43], v[148:151], v[36:39]
    v_and_b32 v40, v20, v12
    v_and_b32 v41, v20, v13
    v_and_b32_dpp v42, v20, v14 row_half_mirror row_mask:0xf bank_mask:0xf
    v_and_b32_dpp v43, v20, v15 row_half_mirror row_mask:0xf bank_mask:0xf
    buffer_load_dwordx4 v[244:247], v2, s[12:15], s83 offen offset:2048 nt
    s_waitcnt vmcnt(4)
    s_cmp_le_u32 s48, 7
    s_cbranch_scc1 L_th24
    s_waitcnt vmcnt(2)
L_th24:
    buffer_load_dwordx4 v[132:135], v4, s[8:11], s74 offen offset:1024 nt
    v_mfma_f32_16x16x32_bf16 v[32:35], v[44:47], v[152:155], v[32:35]
    s_waitcnt vmcnt(3)
    buffer_load_dwordx4 v[136:139], v4, s[8:11], s74 offen offset:2048 nt
    v_mfma_f32_16x16x32_bf16 v[36:39], v[44:47], v[156:159], v[36:39]
    v_and_b32_dpp v44, v20, v12 row_half_mirror row_mask:0xf bank_mask:0xf
    v_and_b32_dpp v45, v20, v13 row_half_mirror row_mask:0xf bank_mask:0xf
    v_and_b32 v46, v20, v14
    v_and_b32 v47, v20, v15
    s_add_u32 s83, s83, s84
    buffer_load_dwordx4 v[248:251], v2, s[12:15], s83 offen offset:0 nt
    s_waitcnt vmcnt(4)
    buffer_load_dwordx4 v[140:143], v4, s[8:11], s74 offen offset:3072 nt
    v_mfma_f32_16x16x32_bf16 v[32:35], v[40:43], v[128:131], v[32:35]
    v_and_b32 v27, 7, v0
    v_lshlrev_b32 v27, 3, v27
    s_waitcnt lgkmcnt(0)
    s_barrier
    ds_read_b64 v[24:25], v27 offset:2848
    s_cmp_eq_u32 s98, 1
    s_cbranch_scc1 L_zok
    s_mov_b32 s92, 200000
    v_mov_b32 v28, 0
    s_mov_b64 exec, 1
L_zpoll:
    buffer_load_dword v29, v28, s[32:35], s99 offen sc1
    s_waitcnt vmcnt(0)
    v_cmp_eq_u32 vcc, 1, v29
    s_cbranch_vccnz L_zdone
    s_sub_u32 s92, s92, 1
    s_cbranch_scc0 L_zpoll
L_zdone:
    s_mov_b64 exec, -1
L_zok:
    s_waitcnt vmcnt(3)
    s_add_u32 s74, s74, s75
    buffer_load_dwordx4 v[144:147], v4, s[8:11], s74 offen offset:0 nt
    s_waitcnt lgkmcnt(0)
    v_max_f32_dpp v26, v24, v24 quad_perm:[1,0,3,2] row_mask:0xf bank_mask:0xf
    v_lshrrev_b32 v7, 2, v1
    s_mul_i32 s88, s3, 288
    v_max_f32_dpp v26, v26, v26 quad_perm:[2,3,0,1] row_mask:0xf bank_mask:0xf
    v_and_b32 v5, 32, v0
    v_bfe_u32 v6, v0, 1, 3
    v_max_f32_dpp v26, v26, v26 row_half_mirror row_mask:0xf bank_mask:0xf
    v_sub_f32 v24, v24, v26
    v_sub_f32 v53, v53, v26
    v_exp_f32 v24, v24
    v_exp_f32 v53, v53
    v_mul_f32 v24, v24, v25
    v_mul_f32 v53, v53, v120
    v_mul_u32_u24 v6, 288, v6
    v_add_f32_dpp v24, v24, v24 quad_perm:[1,0,3,2] row_mask:0xf bank_mask:0xf
    v_and_b32 v25, 1, v0
    v_lshl_add_u32 v6, v25, 7, v6
    v_add_f32_dpp v24, v24, v24 quad_perm:[2,3,0,1] row_mask:0xf bank_mask:0xf
    v_lshl_add_u32 v5, v25, 3, v5
    v_and_b32 v25, 48, v0
    v_add_f32_dpp v24, v24, v24 row_half_mirror row_mask:0xf bank_mask:0xf
    v_add_u32 v6, v25, v6
    v_rcp_f32 v24, v24
    v_and_b32 v3, 0xf0, v1
    v_mul_f32 v52, v53, v24
    v_bfe_u32 v25, v0, 4, 2
    v_lshl_add_u32 v3, v25, 1, v3
    v_bfe_u32 v26, v0, 3, 1
    v_lshl_add_u32 v5, v26, 4, v5
    v_bfe_u32 v26, v0, 4, 1
    v_lshl_add_u32 v5, v26, 2, v5
    v_bfe_u32 v26, v0, 1, 2
    v_add_u32 v5, v26, v5
    v_lshl_add_u32 v5, v5, 2, s88
    s_lshl_b32 s72, s44, 10
    s_lshl_b32 s88, s3, 7
    s_add_u32 s72, s72, s88
    s_lshl_b32 s82, s44, 3
    s_add_u32 s82, s82, s3
    s_lshl_b32 s82, s82, 9
    s_add_u32 s82, s82, 1048576
    v_mfma_f32_16x16x32_bf16 v[36:39], v[40:43], v[132:135], v[36:39]
    v_and_b32 v40, v21, v12
    v_and_b32 v41, v21, v13
    v_and_b32_dpp v42, v21, v14 row_half_mirror row_mask:0xf bank_mask:0xf
    v_and_b32_dpp v43, v21, v15 row_half_mirror row_mask:0xf bank_mask:0xf
    v_perm_b32 v193, v244, v240, s46
    v_perm_b32 v197, v244, v240, s47
    v_perm_b32 v201, v245, v241, s46
    v_perm_b32 v205, v245, v241, s47
    v_perm_b32 v209, v246, v242, s46
    v_perm_b32 v213, v246, v242, s47
    v_perm_b32 v217, v247, v243, s46
    v_perm_b32 v221, v247, v243, s47
    s_waitcnt vmcnt(3)
    buffer_load_dwordx4 v[148:151], v4, s[8:11], s74 offen offset:1024 nt
    v_mfma_f32_16x16x32_bf16 v[32:35], v[44:47], v[136:139], v[32:35]
    buffer_load_dwordx4 v[252:255], v2, s[12:15], s83 offen offset:2048 nt
    s_waitcnt vmcnt(3)
    buffer_load_dwordx4 v[152:155], v4, s[8:11], s74 offen offset:2048 nt
    v_mfma_f32_16x16x32_bf16 v[36:39], v[44:47], v[140:143], v[36:39]
    v_and_b32_dpp v44, v21, v12 row_half_mirror row_mask:0xf bank_mask:0xf
    v_and_b32_dpp v45, v21, v13 row_half_mirror row_mask:0xf bank_mask:0xf
    v_and_b32 v46, v21, v14
    v_and_b32 v47, v21, v15
    s_waitcnt vmcnt(3)
    buffer_load_dwordx4 v[156:159], v4, s[8:11], s74 offen offset:3072 nt
    v_mfma_f32_16x16x32_bf16 v[32:35], v[40:43], v[144:147], v[32:35]
    s_add_u32 s83, s83, s84
    buffer_load_dwordx4 v[224:227], v2, s[12:15], s83 offen offset:0 nt
    s_waitcnt vmcnt(4)
    s_add_u32 s74, s74, s75
    buffer_load_dwordx4 v[128:131], v4, s[8:11], s74 offen offset:0 nt
    v_mfma_f32_16x16x32_bf16 v[36:39], v[40:43], v[148:151], v[36:39]
    v_and_b32 v40, v22, v12
    v_and_b32 v41, v22, v13
    v_and_b32_dpp v42, v22, v14 row_half_mirror row_mask:0xf bank_mask:0xf
    v_and_b32_dpp v43, v22, v15 row_half_mirror row_mask:0xf bank_mask:0xf
    buffer_load_dwordx4 v[132:135], v4, s[8:11], s74 offen offset:1024 nt
    buffer_load_dwordx4 v[136:139], v4, s[8:11], s74 offen offset:2048 nt
    buffer_load_dwordx4 v[228:231], v2, s[12:15], s83 offen offset:2048 nt
    s_waitcnt vmcnt(6)
    buffer_load_dwordx4 v[140:143], v4, s[8:11], s74 offen offset:3072 nt
    v_mfma_f32_16x16x32_bf16 v[32:35], v[44:47], v[152:155], v[32:35]
    v_perm_b32 v194, v252, v248, s46
    v_perm_b32 v198, v252, v248, s47
    v_perm_b32 v202, v253, v249, s46
    v_perm_b32 v206, v253, v249, s47
    v_perm_b32 v210, v254, v250, s46
    v_perm_b32 v214, v254, v250, s47
    v_perm_b32 v218, v255, v251, s46
    v_perm_b32 v222, v255, v251, s47
    s_waitcnt vmcnt(6)
    s_add_u32 s74, s74, s75
    buffer_load_dwordx4 v[144:147], v4, s[8:11], s74 offen offset:0 nt
    v_mfma_f32_16x16x32_bf16 v[36:39], v[44:47], v[156:159], v[36:39]
    v_and_b32_dpp v44, v22, v12 row_half_mirror row_mask:0xf bank_mask:0xf
    v_and_b32_dpp v45, v22, v13 row_half_mirror row_mask:0xf bank_mask:0xf
    v_and_b32 v46, v22, v14
    v_and_b32 v47, v22, v15
    s_waitcnt vmcnt(5)
    buffer_load_dwordx4 v[148:151], v4, s[8:11], s74 offen offset:1024 nt
    v_mfma_f32_16x16x32_bf16 v[32:35], v[40:43], v[128:131], v[32:35]
    s_waitcnt vmcnt(5)
    buffer_load_dwordx4 v[152:155], v4, s[8:11], s74 offen offset:2048 nt
    v_mfma_f32_16x16x32_bf16 v[36:39], v[40:43], v[132:135], v[36:39]
    v_and_b32 v40, v23, v12
    v_and_b32 v41, v23, v13
    v_and_b32_dpp v42, v23, v14 row_half_mirror row_mask:0xf bank_mask:0xf
    v_and_b32_dpp v43, v23, v15 row_half_mirror row_mask:0xf bank_mask:0xf
    s_waitcnt vmcnt(5)
    buffer_load_dwordx4 v[156:159], v4, s[8:11], s74 offen offset:3072 nt
    v_mfma_f32_16x16x32_bf16 v[32:35], v[44:47], v[136:139], v[32:35]
    s_waitcnt vmcnt(4)
    v_mfma_f32_16x16x32_bf16 v[36:39], v[44:47], v[140:143], v[36:39]
    v_and_b32_dpp v44, v23, v12 row_half_mirror row_mask:0xf bank_mask:0xf
    v_and_b32_dpp v45, v23, v13 row_half_mirror row_mask:0xf bank_mask:0xf
    v_and_b32 v46, v23, v14
    v_and_b32 v47, v23, v15
    v_perm_b32 v195, v228, v224, s46
    v_perm_b32 v199, v228, v224, s47
    v_perm_b32 v203, v229, v225, s46
    v_perm_b32 v207, v229, v225, s47
    v_perm_b32 v211, v230, v226, s46
    v_perm_b32 v215, v230, v226, s47
    v_perm_b32 v219, v231, v227, s46
    v_perm_b32 v223, v231, v227, s47
    s_waitcnt vmcnt(3)
    v_mfma_f32_16x16x32_bf16 v[32:35], v[40:43], v[144:147], v[32:35]
    s_waitcnt vmcnt(2)
    v_mfma_f32_16x16x32_bf16 v[36:39], v[40:43], v[148:151], v[36:39]
    s_waitcnt vmcnt(1)
    v_mfma_f32_16x16x32_bf16 v[32:35], v[44:47], v[152:155], v[32:35]
    s_waitcnt vmcnt(0)
    v_mfma_f32_16x16x32_bf16 v[36:39], v[44:47], v[156:159], v[36:39]
    s_nop 5
    v_permlane32_swap_b32 v32, v33
    v_permlane32_swap_b32 v34, v35
    v_permlane32_swap_b32 v36, v37
    v_permlane32_swap_b32 v38, v39
    v_add_f32 v48, v32, v37
    v_add_f32 v49, v34, v39
    v_mul_f32 v48, v48, v52
    v_mul_f32 v49, v49, v52
    v_cvt_pk_bf16_f32 v48, v48, v49
    ds_write_b32 v5, v48 offset:0
    s_waitcnt lgkmcnt(0)
    s_barrier
    ds_read_b128 v[40:43], v6 offset:0
    ds_read_b128 v[44:47], v6 offset:64
    s_mov_b32 s88, 0x41f80000
    s_mov_b32 s90, 0x00ff00ff
    s_mov_b32 s91, 0x00ff00ff
    s_mov_b32 s86, 0x01ff01ff
    s_mov_b32 s87, 0x01ff01ff
    s_waitcnt lgkmcnt(0)
    v_mfma_f32_16x16x32_bf16 v[128:131], v[40:43], v[160:163], 0
    v_mfma_f32_16x16x32_bf16 v[128:131], v[44:47], v[192:195], v[128:131]
    v_mfma_f32_16x16x32_bf16 v[136:139], v[40:43], v[168:171], 0
    v_mfma_f32_16x16x32_bf16 v[136:139], v[44:47], v[200:203], v[136:139]
    v_mfma_f32_16x16x32_bf16 v[132:135], v[40:43], v[164:167], 0
    v_mfma_f32_16x16x32_bf16 v[132:135], v[44:47], v[196:199], v[132:135]
    v_mfma_f32_16x16x32_bf16 v[140:143], v[40:43], v[172:175], 0
    v_mfma_f32_16x16x32_bf16 v[140:143], v[44:47], v[204:207], v[140:143]
    v_mfma_f32_16x16x32_bf16 v[144:147], v[40:43], v[176:179], 0
    v_mfma_f32_16x16x32_bf16 v[144:147], v[44:47], v[208:211], v[144:147]
    v_add_f32_dpp v56, v128, v130 quad_perm:[0,1,2,3] row_mask:0xf bank_mask:0x3
    v_mfma_f32_16x16x32_bf16 v[152:155], v[40:43], v[184:187], 0
    v_mfma_f32_16x16x32_bf16 v[152:155], v[44:47], v[216:219], v[152:155]
    v_add_f32_dpp v56, v129, v131 quad_perm:[0,1,2,3] row_mask:0xf bank_mask:0xc
    v_add_f32_dpp v58, v136, v138 quad_perm:[0,1,2,3] row_mask:0xf bank_mask:0x3
    v_add_f32_dpp v57, v132, v134 quad_perm:[0,1,2,3] row_mask:0xf bank_mask:0x3
    v_mfma_f32_16x16x32_bf16 v[148:151], v[40:43], v[180:183], 0
    v_mfma_f32_16x16x32_bf16 v[148:151], v[44:47], v[212:215], v[148:151]
    v_add_f32_dpp v58, v137, v139 quad_perm:[0,1,2,3] row_mask:0xf bank_mask:0xc
    v_add_f32_dpp v57, v133, v135 quad_perm:[0,1,2,3] row_mask:0xf bank_mask:0xc
    v_add_f32_dpp v59, v140, v142 quad_perm:[0,1,2,3] row_mask:0xf bank_mask:0x3
    v_add_f32_dpp v60, v144, v146 quad_perm:[0,1,2,3] row_mask:0xf bank_mask:0x3
    v_mfma_f32_16x16x32_bf16 v[156:159], v[40:43], v[188:191], 0
    v_mfma_f32_16x16x32_bf16 v[156:159], v[44:47], v[220:223], v[156:159]
    v_add_f32_dpp v59, v141, v143 quad_perm:[0,1,2,3] row_mask:0xf bank_mask:0xc
    v_add_f32_dpp v60, v145, v147 quad_perm:[0,1,2,3] row_mask:0xf bank_mask:0xc
    v_permlane32_swap_b32 v56, v58
    v_add_f32 v56, v56, v58
    v_add_f32_dpp v62, v152, v154 quad_perm:[0,1,2,3] row_mask:0xf bank_mask:0x3
    v_add_f32_dpp v61, v148, v150 quad_perm:[0,1,2,3] row_mask:0xf bank_mask:0x3
    v_permlane32_swap_b32 v57, v59
    v_add_f32 v57, v57, v59
    v_add_f32_dpp v62, v153, v155 quad_perm:[0,1,2,3] row_mask:0xf bank_mask:0xc
    v_add_f32_dpp v61, v149, v151 quad_perm:[0,1,2,3] row_mask:0xf bank_mask:0xc
    v_add_f32_dpp v63, v156, v158 quad_perm:[0,1,2,3] row_mask:0xf bank_mask:0x3
    v_permlane16_swap_b32 v56, v57
    v_add_f32 v56, v56, v57
    v_add_f32_dpp v63, v157, v159 quad_perm:[0,1,2,3] row_mask:0xf bank_mask:0xc
    v_permlane32_swap_b32 v60, v62
    v_add_f32 v60, v60, v62
    v_add_f32_dpp v126, v56, v56 row_ror:8 row_mask:0xf bank_mask:0x3
    v_permlane32_swap_b32 v61, v63
    v_add_f32 v61, v61, v63
    v_add_f32 v48, v126, v30
    v_add_f32 v126, v126, v30
    v_permlane16_swap_b32 v60, v61
    v_add_f32 v60, v60, v61
    s_nop 1
    v_add_f32_dpp v127, v60, v60 row_ror:8 row_mask:0xf bank_mask:0x3
    v_add_f32 v49, v127, v31
    s_mov_b64 exec, s[86:87]
    buffer_atomic_add_f32 v49, v122, s[28:31], s82 offen offset:256 sc0
    buffer_atomic_add_f32 v48, v122, s[28:31], s82 offen sc0
    v_add_f32 v127, v127, v31
    s_waitcnt vmcnt(0)
    v_mov_b32_dpp v50, v48 row_newbcast:8 row_mask:0xf bank_mask:0xf
    v_mov_b32_dpp v51, v49 row_newbcast:8 row_mask:0xf bank_mask:0xf
    v_add_f32 v48, v48, v126
    v_add_f32 v49, v49, v127
    v_cmp_eq_f32 vcc, s88, v50
    v_cmp_eq_f32 s[86:87], s88, v51
    v_cvt_pk_bf16_f32 v48, v48, v49
    s_and_b64 exec, vcc, s[90:91]
    s_cbranch_execz L_nost0
    buffer_store_short v48, v3, s[36:39], s72 offen
L_nost0:
    s_and_b64 exec, s[86:87], s[90:91]
    s_cbranch_execz L_nost1
    buffer_store_short_d16_hi v48, v3, s[36:39], s72 offen offset:8
L_nost1:
L_end:
    s_endpgm
.section .rodata,"a"
.p2align 6
.amdhsa_kernel gated_mix__sliding_block_cached__glu_gated_swiglu__decode_kernel
  .amdhsa_next_free_vgpr 256
  .amdhsa_next_free_sgpr 102
  .amdhsa_accum_offset 256
  .amdhsa_group_segment_fixed_size 0
  .amdhsa_kernarg_size 104
  .amdhsa_user_sgpr_count 2
  .amdhsa_user_sgpr_kernarg_segment_ptr 1
  .amdhsa_system_sgpr_workgroup_id_x 1
  .amdhsa_float_denorm_mode_32 3
.end_amdhsa_kernel
```
